```python
import torch

def _softmax(x, axis=-1):
    return torch.softmax(x, dim=axis)
def _gelu(x):
    return torch.nn.functional.gelu(x, approximate="tanh")
def _silu(x):
    return torch.nn.functional.silu(x)
def _sigmoid(x):
    return torch.sigmoid(x)
def _layernorm(x, axis=-1, eps=1e-5):
    m = x.mean(dim=axis, keepdim=True)
    v = x.var(dim=axis, keepdim=True, unbiased=False)
    return (x - m) / torch.sqrt(v + eps)
def _scatter_add(tgt, idx, src, axis=0):
    return tgt.clone().index_add_(axis, idx, src)
def _segment_sum(src, seg, n):
    out = torch.zeros((n,) + src.shape[1:], dtype=src.dtype)
    return out.index_add_(0, seg, src)
def _pad(x, pw):
    flat = tuple(v for pair in reversed(pw) for v in pair)
    return torch.nn.functional.pad(x, flat)

kernel_name = 'standalone__sliding_block_cached__decode'

def setup_inputs():

    _w = (lambda a: (lambda t: t.to(torch.bfloat16) if t.is_floating_point() else t)(torch.as_tensor(a)))
    B, Sq, D = 8, 1, 448
    Hq, Hkv, Sk, Dh = 16, 8, 8192, 256
    assert Hq % Hkv == 0, (Hq, Hkv)
    return {
        "x": _w((lambda *s: torch.randn(*s, dtype=torch.bfloat16) * 0.8)(B, Sq, D)),
        "k_cache": _w((lambda *s: torch.randn(*s, dtype=torch.bfloat16) * 0.8)(B, Hkv, Sk, Dh)),
        "v_cache": _w((lambda *s: torch.randn(*s, dtype=torch.bfloat16) * 0.05)(B, Hkv, Sk, Dh)),
        "wq": _w((lambda *s: torch.randn(*s, dtype=torch.bfloat16) * 0.8)(D, Hq * Dh) * (D ** -0.5)),
        "wo": _w((lambda *s: torch.randn(*s, dtype=torch.bfloat16) * 0.05)(Hq * Dh, D) * ((Hq * Dh) ** -0.5)),
    }

def reference(x, k_cache, v_cache, wq, wo):
    B, Sq, D = x.shape
    Hq, Dh = 16, 256
    Hkv, Sk = k_cache.shape[1], k_cache.shape[2]
    W = min(4096, max(256, Sk // 4))
    rep = Hq // Hkv
    q = (lambda x, *d: x.permute(*d))((x @ wq).reshape(B, Sq, Hq, Dh), 0, 2, 1, 3)
    k = (lambda x, n, axis: torch.repeat_interleave(x, n, dim=axis))(k_cache[:, :, Sk - W:, :], rep, axis=1)
    v = (lambda x, n, axis: torch.repeat_interleave(x, n, dim=axis))(v_cache[:, :, Sk - W:, :], rep, axis=1)
    scores = torch.einsum("bhqd,bhkd->bhqk", q, k) * (Dh ** -0.5)
    p = _softmax(scores, axis=-1)
    o = torch.einsum("bhqk,bhkd->bhqd", p, v)
    return (lambda x, *d: x.permute(*d))(o, 0, 2, 1, 3).reshape(B, Sq, Hq * Dh) @ wo
```

```asm
; @launch grid=(256,1,1) block=(512,1,1) lds=52288
.amdgcn_target "amdgcn-amd-amdhsa--gfx950"
.text
.globl standalone__sliding_block_cached__decode_kernel
.p2align 8
.type standalone__sliding_block_cached__decode_kernel,@function
standalone__sliding_block_cached__decode_kernel:
    s_cmp_ge_u32 s2, 256
    s_cbranch_scc1 L_end
    s_load_dwordx16 s[48:63], s[0:1], 0
    s_getpc_b64 s[70:71]
    v_mul_u32_u24 v1, 20, v0
    v_lshrrev_b32 v2, 6, v0
    global_load_dword v255, v1, s[70:71] nt
    v_readfirstlane_b32 s3, v2
    v_and_b32 v250, 63, v0
    s_and_b32 s4, s2, 7
    s_lshr_b32 s5, s2, 3
    s_lshr_b32 s6, s2, 5
    s_and_b32 s7, s5, 3
    s_lshl_b32 s8, s6, 3
    s_add_u32 s8, s8, s4
    s_lshl_b32 s12, s2, 3
    s_add_u32 s12, s12, s3
    s_mul_i32 s12, s12, 0x9E3779B1
    s_lshr_b32 s13, s12, 29
    s_lshl_b32 s13, s13, 12
    s_bfe_u32 s12, s12, 0x2001b
    s_lshl_b32 s67, s12, 7
    s_or_b32 s9, s67, s13
    s_lshl_b32 s10, s12, 8
    s_or_b32 s10, s10, s13
    s_and_b32 s12, s12, 2
    v_and_b32 v253, 15, v0
    v_bfe_u32 v254, v0, 4, 2
    v_and_b32 v5, 14, v0
    v_xor_b32 v5, s12, v5
    v_and_b32 v6, 1, v0
    v_lshlrev_b32 v6, 6, v6
    v_lshl_add_u32 v252, v254, 4, v6
    v_lshl_add_u32 v248, v5, 8, v252
    s_lshl_b32 s12, s8, 22
    s_lshl_b32 s13, s7, 18
    s_add_u32 s12, s12, s13
    s_lshl_b32 s13, s3, 15
    s_add_u32 s12, s12, s13
    s_add_u32 s45, s12, 3145728
    s_mov_b32 s18, 0x8000
    s_mov_b32 s19, 0x20000
    s_mov_b32 s22, 0x8000
    s_mov_b32 s23, 0x20000
    s_lshr_b32 s73, s2, 6
    s_mul_i32 s12, s73, 917504
    s_lshl_b32 s13, s4, 10
    s_add_u32 s12, s12, s13
    s_and_b32 s14, s5, 7
    s_lshl_b32 s13, s14, 7
    s_add_u32 s12, s12, s13
    s_lshl_b32 s13, s3, 17
    s_add_u32 s12, s12, s13
    s_mul_i32 s13, s73, 224
    s_cmp_eq_u32 s3, 7
    s_cselect_b32 s12, s13, s12
    s_cselect_b32 s74, 16, 8192
    s_cselect_b32 s75, 896, 16
    s_mov_b32 s40, 65536
    s_cselect_b32 s40, 128, s40
    s_mov_b32 s34, 3670016
    s_cselect_b32 s34, 7168, s34
    s_mov_b32 s35, 0x20000
    v_lshrrev_b32 v240, 3, v250
    v_and_b32 v241, 7, v250
    v_mul_u32_u24 v242, s74, v240
    v_mad_u32_u24 v242, v241, s75, v242
    s_waitcnt lgkmcnt(0)
    s_cselect_b32 s32, s48, s54
    s_cselect_b32 s33, s49, s55
    s_add_u32 s16, s50, s45
    s_addc_u32 s17, s51, 0
    s_xor_b32 s11, s9, 0
    buffer_load_dwordx4 v[0:3], v248, s[16:19], s11 offen nt
    s_xor_b32 s11, s9, 128
    buffer_load_dwordx4 v[4:7], v248, s[16:19], s11 offen nt
    s_add_u32 s24, s62, 0
    s_addc_u32 s25, s63, 0
    s_load_dword s15, s[24:25], 0
    s_lshl_b32 m0, s3, 11
    s_add_u32 s40, s40, s12
    buffer_load_dwordx4 v242, s[32:35], s12 offen nt lds
    s_add_u32 m0, m0, 1024
    s_add_u32 s20, s52, s45
    s_addc_u32 s21, s53, 0
    buffer_load_dwordx4 v242, s[32:35], s40 offen nt lds
    v_lshlrev_b32 v249, 4, v253
    v_lshl_add_u32 v249, v254, 10, v249
    s_mov_b32 s26, 5898240
    s_mov_b32 s27, 0x20000
    s_mov_b32 s36, s58
    s_mov_b32 s37, s59
    s_mov_b32 s38, 7168
    s_mov_b32 s39, 0x20000
    s_lshl_b32 s68, s4, 2
    s_add_u32 s68, s68, s7
    s_getreg_b32 s49, hwreg(HW_REG_XCC_ID, 0, 4)
    s_mov_b32 s50, 0
    s_mov_b32 s51, 0
    s_lshl_b32 s49, s49, 28
    s_mov_b32 s64, 0x05040100
    s_mov_b32 s65, 0x07060302
    s_mov_b32 s66, 0x3db8aa3b
    s_mov_b32 s69, 0xff
    s_mov_b32 s76, 0x7060500
    s_mov_b32 s77, 0x7060501
    s_mov_b32 s78, 0x7060502
    s_mov_b32 s79, 0x7060503
    v_lshrrev_b32 v224, 3, v253
    v_lshl_add_u32 v252, v224, 9, v252
    v_or_b32 v252, s67, v252
    s_lshl_b32 s12, s4, 2
    s_add_u32 s12, s12, s73
    s_lshl_b32 s12, s12, 11
    s_lshl_b32 s13, s14, 8
    s_add_u32 s12, s12, s13
    s_lshl_b32 s13, s3, 6
    s_add_u32 s12, s12, s13
    s_add_u32 s100, s12, 1179648
    s_lshr_b32 s12, s3, 2
    s_lshl_b32 s13, s4, 1
    s_add_u32 s12, s12, s13
    s_lshl_b32 s12, s12, 1
    s_lshr_b32 s13, s7, 1
    s_add_u32 s12, s12, s13
    s_lshl_b32 s12, s12, 5
    s_and_b32 s13, s7, 1
    s_add_u32 s12, s12, s13
    s_lshl_b32 s12, s12, 2
    s_and_b32 s13, s3, 3
    s_add_u32 s12, s12, s13
    s_mul_i32 s12, s12, 896
    s_min_u32 s13, s6, 6
    s_lshl_b32 s13, s13, 7
    s_add_u32 s12, s12, s13
    s_add_u32 s28, s56, s12
    s_addc_u32 s29, s57, 0
    s_sub_u32 s30, 3670016, s12
    s_mov_b32 s31, 0x20000
    s_cmp_eq_u32 s6, 7
    s_cselect_b32 s30, 0, s30
    v_mul_u32_u24 v243, 7168, v240
    v_lshl_add_u32 v243, v241, 4, v243
    v_lshrrev_b32 v224, 2, v253
    v_and_b32 v225, 3, v253
    v_lshlrev_b32 v225, 3, v225
    v_lshl_add_u32 v224, v224, 7, v225
    s_and_b32 s12, s3, 3
    s_lshl_b32 s12, s12, 5
    v_add_u32 v224, s12, v224
    v_lshl_add_u32 v225, v254, 9, v224
    v_lshl_add_u32 v224, v254, 10, v224
    v_lshlrev_b32 v226, 4, v241
    v_lshrrev_b32 v227, 1, v254
    v_lshl_add_u32 v227, v227, 7, v226
    v_and_b32 v228, 1, v254
    v_lshl_add_u32 v227, v228, 3, v227
    v_lshl_add_u32 v226, v254, 7, v226
    v_lshlrev_b32 v228, 16, v253
    v_lshl_add_u32 v228, v254, 4, v228
    s_xor_b32 s11, s9, 256
    buffer_load_dwordx4 v[8:11], v248, s[16:19], s11 offen nt
    s_waitcnt vmcnt(4)
    s_xor_b32 s11, s9, 384
    buffer_load_dwordx4 v[12:15], v248, s[16:19], s11 offen nt
    s_waitcnt vmcnt(4)
    s_xor_b32 s11, s9, 4096
    buffer_load_dwordx4 v[16:19], v248, s[16:19], s11 offen nt
    s_waitcnt vmcnt(2)
    s_xor_b32 s11, s9, 4224
    buffer_load_dwordx4 v[20:23], v248, s[16:19], s11 offen nt
    s_waitcnt vmcnt(2)
    s_xor_b32 s11, s9, 4352
    buffer_load_dwordx4 v[24:27], v248, s[16:19], s11 offen nt
    s_waitcnt vmcnt(2)
    s_xor_b32 s11, s9, 4480
    buffer_load_dwordx4 v[28:31], v248, s[16:19], s11 offen nt
    s_waitcnt vmcnt(2)
    s_xor_b32 s11, s9, 8192
    buffer_load_dwordx4 v[32:35], v248, s[16:19], s11 offen nt
    s_waitcnt vmcnt(2)
    s_xor_b32 s11, s9, 8320
    buffer_load_dwordx4 v[36:39], v248, s[16:19], s11 offen nt
    s_waitcnt vmcnt(8)
    s_waitcnt lgkmcnt(0)
    s_add_u32 s15, s15, 0x01010101
    s_xor_b32 s48, s15, s49
    v_mov_b32 v251, s48
    s_barrier
    s_cmp_ge_u32 s3, 4
    s_cbranch_scc1 L_noq
    ds_read_b64 v[172:173], v227 offset:15872
    ds_read_b64_tr_b16 v[140:141], v225 offset:12288
    ds_read_b128 v[160:163], v226 offset:14336
    ds_read_b64_tr_b16 v[128:129], v224 offset:0
    ds_read_b64_tr_b16 v[130:131], v224 offset:512
    ds_read_b128 v[164:167], v226 offset:14848
    ds_read_b64_tr_b16 v[132:133], v224 offset:4096
    ds_read_b64_tr_b16 v[134:135], v224 offset:4608
    ds_read_b128 v[168:171], v226 offset:15360
    ds_read_b64_tr_b16 v[136:137], v224 offset:8192
    ds_read_b64_tr_b16 v[138:139], v224 offset:8704
    s_waitcnt lgkmcnt(9)
    v_mfma_f32_16x16x16_bf16 v[212:215], v[140:141], v[172:173], 0
    s_waitcnt lgkmcnt(6)
    v_mfma_f32_16x16x32_bf16 v[208:211], v[128:131], v[160:163], 0
    s_waitcnt lgkmcnt(3)
    v_mfma_f32_16x16x32_bf16 v[208:211], v[132:135], v[164:167], v[208:211]
    s_waitcnt lgkmcnt(0)
    v_mfma_f32_16x16x32_bf16 v[208:211], v[136:139], v[168:171], v[208:211]
    s_mov_b32 exec_lo, 0x00ff00ff
    s_mov_b32 exec_hi, 0x00ff00ff
    s_nop 5
    v_add_f32 v208, v208, v212
    v_add_f32 v209, v209, v213
    v_add_f32 v210, v210, v214
    v_add_f32 v211, v211, v215
    v_perm_b32 v208, v208, v251, s76
    v_perm_b32 v209, v209, v251, s77
    v_perm_b32 v210, v210, v251, s78
    v_perm_b32 v211, v211, v251, s79
    buffer_store_dwordx4 v[208:211], v228, s[24:27], s100 offen
    s_mov_b64 exec, -1
L_noq:
    s_lshl_b32 s12, s5, 3
    s_add_u32 s12, s12, s3
    s_and_b32 s13, s12, 31
    s_cmp_eq_u32 s13, 13
    s_cselect_b32 s60, s6, 9
    s_and_b32 s13, s12, 63
    s_mul_i32 s61, s8, 256
    s_cmp_eq_u32 s13, 54
    s_cselect_b32 s60, 8, s60
    s_cselect_b32 s61, 0, s61
    s_add_u32 s61, s61, 32768
    s_lshl_b32 s72, s4, 7
    s_add_u32 s72, s72, 4096
    v_lshlrev_b32 v188, 2, v250
    v_mul_u32_u24 v190, 256, v250
    v_mov_b32 v191, s15
    v_and_b32 v240, 3, v250
    v_lshrrev_b32 v241, 2, v250
    v_lshlrev_b32 v242, 11, v240
    v_lshl_add_u32 v242, v241, 4, v242
    s_lshl_b32 s12, s8, 13
    s_lshl_b32 s13, s3, 8
    s_add_u32 s12, s12, s13
    s_add_u32 s40, s12, 1179648
    s_lshl_b32 s12, s3, 7
    v_lshlrev_b32 v241, 3, v241
    v_add_u32 v241, s12, v241
    v_xor_b32 v232, 0, v252
    v_xor_b32 v233, 128, v252
    v_xor_b32 v234, 256, v252
    v_xor_b32 v235, 384, v252
    s_xor_b32 s11, s9, 8448
    buffer_load_dwordx4 v[40:43], v248, s[16:19], s11 offen nt
    s_waitcnt vmcnt(3)
    s_xor_b32 s11, s9, 8576
    buffer_load_dwordx4 v[44:47], v248, s[16:19], s11 offen nt
    s_xor_b32 s11, s9, 12288
    buffer_load_dwordx4 v[48:51], v248, s[16:19], s11 offen nt
    s_waitcnt vmcnt(4)
    s_xor_b32 s11, s9, 12416
    buffer_load_dwordx4 v[52:55], v248, s[16:19], s11 offen nt
    s_mov_b64 exec, 7
    s_lshl_b32 s12, s4, 7
    s_add_u32 s12, s12, 4096
    v_lshlrev_b32 v255, 10, v250
    buffer_load_dword v255, v255, s[24:27], s12 offen
    s_mov_b64 exec, -1
    s_waitcnt vmcnt(4)
    s_xor_b32 s11, s9, 12544
    buffer_load_dwordx4 v[56:59], v248, s[16:19], s11 offen nt
    s_waitcnt vmcnt(4)
    s_xor_b32 s11, s9, 12672
    buffer_load_dwordx4 v[60:63], v248, s[16:19], s11 offen nt
    s_cmp_eq_u32 s60, 0
    s_cbranch_scc1 L_gr15
L_gs15:
    s_waitcnt vmcnt(3)
    s_xor_b32 s11, s9, 16384
    buffer_load_dwordx4 v[64:67], v248, s[16:19], s11 offen nt
    s_cmp_eq_u32 s60, 1
    s_cbranch_scc1 L_gr16
L_gs16:
    s_waitcnt vmcnt(2)
    s_xor_b32 s11, s9, 16512
    buffer_load_dwordx4 v[68:71], v248, s[16:19], s11 offen nt
    s_cmp_eq_u32 s60, 2
    s_cbranch_scc1 L_gr17
L_gs17:
    s_waitcnt vmcnt(2)
    s_xor_b32 s11, s9, 16640
    buffer_load_dwordx4 v[72:75], v248, s[16:19], s11 offen nt
    s_cmp_eq_u32 s60, 3
    s_cbranch_scc1 L_gr18
L_gs18:
    s_waitcnt vmcnt(2)
    s_xor_b32 s11, s9, 16768
    buffer_load_dwordx4 v[76:79], v248, s[16:19], s11 offen nt
    s_cmp_eq_u32 s60, 4
    s_cbranch_scc1 L_gr19
L_gs19:
    s_cmp_eq_u32 s60, 8
    s_cbranch_scc1 L_gq19
L_gt19:
    s_waitcnt vmcnt(2)
    s_xor_b32 s11, s9, 20480
    buffer_load_dwordx4 v[80:83], v248, s[16:19], s11 offen nt
    s_cmp_eq_u32 s60, 5
    s_cbranch_scc1 L_gr20
L_gs20:
    s_waitcnt vmcnt(2)
    s_xor_b32 s11, s9, 20608
    buffer_load_dwordx4 v[84:87], v248, s[16:19], s11 offen nt
    s_cmp_eq_u32 s60, 6
    s_cbranch_scc1 L_gr21
L_gs21:
    s_waitcnt vmcnt(2)
    s_xor_b32 s11, s9, 20736
    buffer_load_dwordx4 v[88:91], v248, s[16:19], s11 offen nt
    s_cmp_eq_u32 s60, 7
    s_cbranch_scc1 L_gr22
L_gs22:
    s_mov_b32 s55, s40
    buffer_load_dwordx4 v[244:247], v242, s[24:27], s55 offen sc1 nt
    s_lshl_b32 s12, s3, 2
    v_mov_b32 v240, s12
    v_and_b32 v229, 7, v250
    v_lshlrev_b32 v229, 2, v229
    s_waitcnt vmcnt(3)
    s_xor_b32 s11, s9, 20864
    buffer_load_dwordx4 v[92:95], v248, s[16:19], s11 offen nt
    s_waitcnt vmcnt(3)
    s_xor_b32 s11, s9, 24576
    buffer_load_dwordx4 v[96:99], v248, s[16:19], s11 offen nt
    s_cmp_eq_u32 s60, 8
    s_cbranch_scc1 L_gq24
L_gt24:
    s_waitcnt vmcnt(3)
    s_xor_b32 s11, s9, 24704
    buffer_load_dwordx4 v[100:103], v248, s[16:19], s11 offen nt
    s_waitcnt vmcnt(2)
    s_xor_b32 s11, s9, 24832
    buffer_load_dwordx4 v[104:107], v248, s[16:19], s11 offen nt
    s_waitcnt vmcnt(2)
    s_xor_b32 s11, s9, 24960
    buffer_load_dwordx4 v[108:111], v248, s[16:19], s11 offen nt
    s_mov_b32 s14, 32
    s_waitcnt vmcnt(5)
L_qa:
    s_mov_b32 s54, s48
L_q0:
    v_xor_b32_sdwa v244, v244, s54 dst_sel:DWORD dst_unused:UNUSED_PAD src0_sel:DWORD src1_sel:BYTE_0
    v_xor_b32_sdwa v245, v245, s54 dst_sel:DWORD dst_unused:UNUSED_PAD src0_sel:DWORD src1_sel:BYTE_1
    v_xor_b32_sdwa v246, v246, s54 dst_sel:DWORD dst_unused:UNUSED_PAD src0_sel:DWORD src1_sel:BYTE_2
    v_xor_b32_sdwa v247, v247, s54 dst_sel:DWORD dst_unused:UNUSED_PAD src0_sel:DWORD src1_sel:BYTE_3
    v_or3_b32 v224, v244, v245, v246
    v_or_b32 v224, v224, v247
    v_cmp_ne_u32_sdwa vcc, v224, 0 src0_sel:BYTE_0 src1_sel:DWORD
    s_and_b64 exec, vcc, vcc
    s_cbranch_scc0 L_q1
    s_xor_b32 s55, s55, s50
    s_xor_b32 s54, s54, s51
    buffer_load_dwordx4 v[244:247], v242, s[24:27], s55 offen sc1 nt
    s_sub_u32 s14, s14, 1
    s_waitcnt vmcnt(0)
    s_cbranch_scc0 L_q0
L_q1:
    s_mov_b64 exec, -1
    s_lshr_b32 s12, s14, 31
    v_add_f32_dpp v244, v244, v244 quad_perm:[1,0,3,2] row_mask:0xf bank_mask:0xf
    v_add_f32_dpp v245, v245, v245 quad_perm:[1,0,3,2] row_mask:0xf bank_mask:0xf
    v_add_f32_dpp v246, v246, v246 quad_perm:[1,0,3,2] row_mask:0xf bank_mask:0xf
    v_add_f32_dpp v247, v247, v247 quad_perm:[1,0,3,2] row_mask:0xf bank_mask:0xf
    v_add_f32_dpp v244, v244, v244 quad_perm:[2,3,0,1] row_mask:0xf bank_mask:0xf
    v_add_f32_dpp v245, v245, v245 quad_perm:[2,3,0,1] row_mask:0xf bank_mask:0xf
    v_add_f32_dpp v246, v246, v246 quad_perm:[2,3,0,1] row_mask:0xf bank_mask:0xf
    v_add_f32_dpp v247, v247, v247 quad_perm:[2,3,0,1] row_mask:0xf bank_mask:0xf
    v_mov_b32 v224, s12
    v_cvt_pk_bf16_f32 v244, v244, v245
    v_cvt_pk_bf16_f32 v245, v246, v247
    ds_write_b32 v240, v224 offset:52224
    ds_write_b64 v241, v[244:245] offset:51200
    s_waitcnt lgkmcnt(0)
    s_barrier
    ds_read_b32 v224, v229 offset:52224
    ds_read_b128 v[192:195], v232 offset:51200
    ds_read_b128 v[196:199], v233 offset:51200
    ds_read_b128 v[200:203], v234 offset:51200
    ds_read_b128 v[204:207], v235 offset:51200
    s_waitcnt lgkmcnt(4)
    v_cmp_lt_u32 vcc, s50, v224
    s_cbranch_vccnz L_slow
    s_waitcnt vmcnt(2)
    s_xor_b32 s11, s9, 28672
    buffer_load_dwordx4 v[112:115], v248, s[16:19], s11 offen nt
    s_mov_b64 exec, 15
    buffer_load_dword v255, v188, s[24:27], s72 offen offset:0 sc1 nt
    s_mov_b64 exec, -1
    s_waitcnt lgkmcnt(0)
    v_mfma_f32_16x16x32_bf16 v[208:211], v[0:3], v[192:195], 0
    v_mfma_f32_16x16x32_bf16 v[208:211], v[4:7], v[196:199], v[208:211]
    v_mfma_f32_16x16x32_bf16 v[208:211], v[8:11], v[200:203], v[208:211]
    v_mfma_f32_16x16x32_bf16 v[208:211], v[12:15], v[204:207], v[208:211]
    v_mfma_f32_16x16x32_bf16 v[212:215], v[16:19], v[192:195], 0
    v_mfma_f32_16x16x32_bf16 v[212:215], v[20:23], v[196:199], v[212:215]
    v_mfma_f32_16x16x32_bf16 v[212:215], v[24:27], v[200:203], v[212:215]
    v_mfma_f32_16x16x32_bf16 v[212:215], v[28:31], v[204:207], v[212:215]
    v_mfma_f32_16x16x32_bf16 v[216:219], v[32:35], v[192:195], 0
    v_mfma_f32_16x16x32_bf16 v[216:219], v[36:39], v[196:199], v[216:219]
    v_mfma_f32_16x16x32_bf16 v[216:219], v[40:43], v[200:203], v[216:219]
    v_mfma_f32_16x16x32_bf16 v[216:219], v[44:47], v[204:207], v[216:219]
    v_mfma_f32_16x16x32_bf16 v[220:223], v[48:51], v[192:195], 0
    v_mfma_f32_16x16x32_bf16 v[220:223], v[52:55], v[196:199], v[220:223]
    v_mfma_f32_16x16x32_bf16 v[220:223], v[56:59], v[200:203], v[220:223]
    v_mfma_f32_16x16x32_bf16 v[220:223], v[60:63], v[204:207], v[220:223]
    s_waitcnt vmcnt(3)
    s_xor_b32 s11, s9, 28800
    buffer_load_dwordx4 v[116:119], v248, s[16:19], s11 offen nt
    v_mfma_f32_16x16x32_bf16 v[224:227], v[64:67], v[192:195], 0
    v_mfma_f32_16x16x32_bf16 v[224:227], v[68:71], v[196:199], v[224:227]
    v_mfma_f32_16x16x32_bf16 v[224:227], v[72:75], v[200:203], v[224:227]
    v_mfma_f32_16x16x32_bf16 v[224:227], v[76:79], v[204:207], v[224:227]
    v_mfma_f32_16x16x32_bf16 v[228:231], v[80:83], v[192:195], 0
    v_mfma_f32_16x16x32_bf16 v[228:231], v[84:87], v[196:199], v[228:231]
    v_mfma_f32_16x16x32_bf16 v[228:231], v[88:91], v[200:203], v[228:231]
    v_mfma_f32_16x16x32_bf16 v[228:231], v[92:95], v[204:207], v[228:231]
    v_mfma_f32_16x16x32_bf16 v[232:235], v[96:99], v[192:195], 0
    v_mfma_f32_16x16x32_bf16 v[232:235], v[100:103], v[196:199], v[232:235]
    v_mfma_f32_16x16x32_bf16 v[232:235], v[104:107], v[200:203], v[232:235]
    s_waitcnt vmcnt(3)
    s_xor_b32 s11, s9, 28928
    buffer_load_dwordx4 v[120:123], v248, s[16:19], s11 offen nt
    s_waitcnt vmcnt(2)
    v_xor_b32 v255, v255, v251
    v_cmp_ge_u32 s[96:97], 64, v255
    v_mov_b32 v187, 30
    s_nop 0
    v_cndmask_b32 v255, v187, v255, s[96:97]
    s_nop 1
    v_add_u32_dpp v255, v255, v255 quad_perm:[1,0,3,2] row_mask:0xf bank_mask:0xf
    s_nop 1
    v_add_u32_dpp v255, v255, v255 quad_perm:[2,3,0,1] row_mask:0xf bank_mask:0xf
    s_nop 0
    v_readfirstlane_b32 s99, v255
    s_mov_b32 s96, 0x801fffff
    s_mov_b32 s97, 0x80094a52
    s_cmp_ge_u32 s99, 52
    s_cselect_b32 s97, 0x80089224, s97
    s_cmp_ge_u32 s99, 76
    s_cselect_b32 s97, 0x80008410, s97
    s_cmp_ge_u32 s99, 100
    s_cselect_b32 s97, 0x0, s97
    s_cmp_ge_u32 s99, 124
    s_cselect_b32 s96, 0x801b6edb, s96
    s_cmp_ge_u32 s99, 156
    s_cselect_b32 s96, 0x80094a52, s96
    s_cmp_ge_u32 s99, 184
    s_cselect_b32 s96, 0x0, s96
    s_mul_i32 s101, s99, 6
    s_lshr_b32 s101, s101, 6
    v_mfma_f32_16x16x32_bf16 v[232:235], v[108:111], v[204:207], v[232:235]
    s_bitcmp1_b32 s96, 31
    s_cbranch_scc0 L_fx31
    s_waitcnt vmcnt(3)
    s_bitcmp1_b32 s97, 31
    s_cbranch_scc0 L_fx31
    s_waitcnt vmcnt(1)
L_fx31:
    s_xor_b32 s11, s9, 29056
    buffer_load_dwordx4 v[124:127], v248, s[16:19], s11 offen nt
    s_waitcnt vmcnt(4)
    s_bitcmp1_b32 s96, 0
    s_cbranch_scc0 L_fx32
    s_waitcnt vmcnt(2)
L_fx32:
    s_xor_b32 s11, s10, 0
    buffer_load_dwordx4 v[128:131], v249, s[20:23], s11 offen nt
    v_mfma_f32_16x16x32_bf16 v[236:239], v[112:115], v[192:195], 0
    s_waitcnt vmcnt(3)
    s_bitcmp1_b32 s96, 1
    s_cbranch_scc0 L_fx33
    s_waitcnt vmcnt(2)
    s_bitcmp1_b32 s97, 1
    s_cbranch_scc0 L_fx33
    s_waitcnt vmcnt(1)
L_fx33:
    s_xor_b32 s11, s10, 512
    buffer_load_dwordx4 v[132:135], v249, s[20:23], s11 offen nt
    v_mfma_f32_16x16x32_bf16 v[236:239], v[116:119], v[196:199], v[236:239]
    s_waitcnt vmcnt(3)
    s_bitcmp1_b32 s96, 2
    s_cbranch_scc0 L_fx34
    s_waitcnt vmcnt(2)
    s_bitcmp1_b32 s97, 2
    s_cbranch_scc0 L_fx34
    s_waitcnt vmcnt(1)
L_fx34:
    s_xor_b32 s11, s10, 4096
    buffer_load_dwordx4 v[136:139], v249, s[20:23], s11 offen nt
    v_mfma_f32_16x16x32_bf16 v[236:239], v[120:123], v[200:203], v[236:239]
    s_waitcnt vmcnt(3)
    s_bitcmp1_b32 s96, 3
    s_cbranch_scc0 L_fx35
    s_waitcnt vmcnt(2)
L_fx35:
    s_xor_b32 s11, s10, 4608
    buffer_load_dwordx4 v[140:143], v249, s[20:23], s11 offen nt
    v_mfma_f32_16x16x32_bf16 v[236:239], v[124:127], v[204:207], v[236:239]
    s_mov_b32 vcc_lo, 0xaaaaaaaa
    s_mov_b32 vcc_hi, 0xaaaaaaaa
    v_cndmask_b32 v192, v208, v209, vcc
    v_cndmask_b32 v193, v210, v211, vcc
    v_cndmask_b32 v194, v212, v213, vcc
    v_cndmask_b32 v195, v214, v215, vcc
    v_cndmask_b32 v196, v216, v217, vcc
    v_cndmask_b32 v197, v218, v219, vcc
    v_cndmask_b32 v198, v220, v221, vcc
    v_cndmask_b32 v199, v222, v223, vcc
    v_cndmask_b32 v200, v224, v225, vcc
    v_cndmask_b32 v201, v226, v227, vcc
    v_cndmask_b32 v202, v228, v229, vcc
    v_cndmask_b32 v203, v230, v231, vcc
    v_cndmask_b32 v204, v232, v233, vcc
    v_cndmask_b32 v205, v234, v235, vcc
    v_cndmask_b32 v206, v236, v237, vcc
    v_cndmask_b32 v207, v238, v239, vcc
    v_add_f32_dpp v192, v192, v192 quad_perm:[1,0,3,2] row_mask:0xf bank_mask:0xf
    v_add_f32_dpp v193, v193, v193 quad_perm:[1,0,3,2] row_mask:0xf bank_mask:0xf
    v_add_f32_dpp v194, v194, v194 quad_perm:[1,0,3,2] row_mask:0xf bank_mask:0xf
    v_add_f32_dpp v195, v195, v195 quad_perm:[1,0,3,2] row_mask:0xf bank_mask:0xf
    v_add_f32_dpp v196, v196, v196 quad_perm:[1,0,3,2] row_mask:0xf bank_mask:0xf
    v_add_f32_dpp v197, v197, v197 quad_perm:[1,0,3,2] row_mask:0xf bank_mask:0xf
    v_add_f32_dpp v198, v198, v198 quad_perm:[1,0,3,2] row_mask:0xf bank_mask:0xf
    v_add_f32_dpp v199, v199, v199 quad_perm:[1,0,3,2] row_mask:0xf bank_mask:0xf
    v_add_f32_dpp v200, v200, v200 quad_perm:[1,0,3,2] row_mask:0xf bank_mask:0xf
    v_add_f32_dpp v201, v201, v201 quad_perm:[1,0,3,2] row_mask:0xf bank_mask:0xf
    v_add_f32_dpp v202, v202, v202 quad_perm:[1,0,3,2] row_mask:0xf bank_mask:0xf
    v_add_f32_dpp v203, v203, v203 quad_perm:[1,0,3,2] row_mask:0xf bank_mask:0xf
    v_add_f32_dpp v204, v204, v204 quad_perm:[1,0,3,2] row_mask:0xf bank_mask:0xf
    v_add_f32_dpp v205, v205, v205 quad_perm:[1,0,3,2] row_mask:0xf bank_mask:0xf
    v_add_f32_dpp v206, v206, v206 quad_perm:[1,0,3,2] row_mask:0xf bank_mask:0xf
    v_add_f32_dpp v207, v207, v207 quad_perm:[1,0,3,2] row_mask:0xf bank_mask:0xf
    v_cvt_pk_bf16_f32 v208, v192, v193
    v_cvt_pk_bf16_f32 v209, v194, v195
    v_cvt_pk_bf16_f32 v210, v196, v197
    v_cvt_pk_bf16_f32 v211, v198, v199
    v_cvt_pk_bf16_f32 v212, v200, v201
    v_cvt_pk_bf16_f32 v213, v202, v203
    v_cvt_pk_bf16_f32 v214, v204, v205
    v_cvt_pk_bf16_f32 v215, v206, v207
    v_lshlrev_b32 v224, 16, v208
    v_and_b32 v225, 0xffff0000, v208
    v_lshlrev_b32 v226, 16, v209
    v_and_b32 v227, 0xffff0000, v209
    v_lshlrev_b32 v228, 16, v210
    v_and_b32 v229, 0xffff0000, v210
    v_lshlrev_b32 v230, 16, v211
    v_and_b32 v231, 0xffff0000, v211
    v_lshlrev_b32 v232, 16, v212
    v_and_b32 v233, 0xffff0000, v212
    v_lshlrev_b32 v234, 16, v213
    v_and_b32 v235, 0xffff0000, v213
    v_lshlrev_b32 v236, 16, v214
    v_and_b32 v237, 0xffff0000, v214
    v_lshlrev_b32 v238, 16, v215
    v_and_b32 v239, 0xffff0000, v215
    v_max_f32 v240, v224, v225
    v_max3_f32 v240, v240, v226, v227
    v_max3_f32 v240, v240, v228, v229
    v_max3_f32 v240, v240, v230, v231
    v_max3_f32 v240, v240, v232, v233
    v_max3_f32 v240, v240, v234, v235
    v_max3_f32 v240, v240, v236, v237
    v_max3_f32 v240, v240, v238, v239
    v_mov_b32 v242, v240
    s_nop 1
    v_permlane32_swap_b32 v240, v242
    s_nop 1
    v_max_f32 v240, v240, v242
    v_mov_b32 v242, v240
    s_nop 1
    v_permlane16_swap_b32 v240, v242
    s_nop 1
    v_max_f32 v240, v240, v242
    s_waitcnt vmcnt(3)
    s_bitcmp1_b32 s96, 4
    s_cbranch_scc0 L_fx36
    s_waitcnt vmcnt(2)
    s_bitcmp1_b32 s97, 4
    s_cbranch_scc0 L_fx36
    s_waitcnt vmcnt(1)
L_fx36:
    s_xor_b32 s11, s10, 8192
    buffer_load_dwordx4 v[144:147], v249, s[20:23], s11 offen nt
    v_sub_f32 v224, v224, v240
    v_sub_f32 v225, v225, v240
    v_sub_f32 v226, v226, v240
    v_sub_f32 v227, v227, v240
    v_sub_f32 v228, v228, v240
    v_sub_f32 v229, v229, v240
    v_sub_f32 v230, v230, v240
    v_sub_f32 v231, v231, v240
    v_sub_f32 v232, v232, v240
    v_sub_f32 v233, v233, v240
    v_sub_f32 v234, v234, v240
    v_sub_f32 v235, v235, v240
    v_sub_f32 v236, v236, v240
    v_sub_f32 v237, v237, v240
    v_sub_f32 v238, v238, v240
    v_sub_f32 v239, v239, v240
    v_mul_f32 v224, s66, v224
    v_mul_f32 v225, s66, v225
    v_mul_f32 v226, s66, v226
    v_mul_f32 v227, s66, v227
    v_mul_f32 v228, s66, v228
    v_mul_f32 v229, s66, v229
    v_mul_f32 v230, s66, v230
    v_mul_f32 v231, s66, v231
    v_mul_f32 v232, s66, v232
    v_mul_f32 v233, s66, v233
    v_mul_f32 v234, s66, v234
    v_mul_f32 v235, s66, v235
    v_mul_f32 v236, s66, v236
    v_mul_f32 v237, s66, v237
    v_mul_f32 v238, s66, v238
    v_mul_f32 v239, s66, v239
    v_exp_f32 v224, v224
    v_exp_f32 v225, v225
    v_exp_f32 v226, v226
    v_exp_f32 v227, v227
    v_exp_f32 v228, v228
    v_exp_f32 v229, v229
    v_exp_f32 v230, v230
    v_exp_f32 v231, v231
    v_exp_f32 v232, v232
    v_exp_f32 v233, v233
    v_exp_f32 v234, v234
    v_exp_f32 v235, v235
    v_exp_f32 v236, v236
    v_exp_f32 v237, v237
    v_exp_f32 v238, v238
    v_exp_f32 v239, v239
    s_lshl_b32 s12, s8, 10
    s_add_u32 s41, s12, 65536
    v_add_f32 v241, v224, v225
    v_add_f32 v241, v241, v226
    v_add_f32 v241, v241, v227
    v_add_f32 v241, v241, v228
    v_add_f32 v241, v241, v229
    v_add_f32 v241, v241, v230
    v_add_f32 v241, v241, v231
    v_add_f32 v241, v241, v232
    v_add_f32 v241, v241, v233
    v_add_f32 v241, v241, v234
    v_add_f32 v241, v241, v235
    v_add_f32 v241, v241, v236
    v_add_f32 v241, v241, v237
    v_add_f32 v241, v241, v238
    v_add_f32 v241, v241, v239
    v_mov_b32 v242, v241
    s_nop 1
    v_permlane32_swap_b32 v241, v242
    s_nop 1
    v_add_f32 v241, v241, v242
    v_mov_b32 v242, v241
    s_nop 1
    v_permlane16_swap_b32 v241, v242
    s_nop 1
    v_add_f32 v241, v241, v242
    v_perm_b32 v244, v240, v251, s76
    v_perm_b32 v245, v241, v251, s77
    v_perm_b32 v246, v240, v251, s78
    v_perm_b32 v247, v241, v251, s79
    s_lshl_b32 s13, s7, 3
    s_add_u32 s13, s13, s3
    s_lshl_b32 s13, s13, 5
    s_add_u32 s13, s13, s41
    v_lshlrev_b32 v242, 1, v250
    s_mov_b64 exec, 0x101
    buffer_store_dwordx4 v[244:247], v242, s[24:27], s13 offen
    s_cmp_lg_u32 s50, 0
    s_cbranch_scc1 L_mlB
L_mlR:
    s_mov_b64 exec, -1
    v_and_b32 v198, 7, v253
    v_lshl_add_u32 v198, v254, 3, v198
    v_lshlrev_b32 v198, 5, v198
    v_and_b32 v196, 8, v253
    v_lshl_add_u32 v198, v196, 1, v198
    s_waitcnt vmcnt(4)
    s_bitcmp1_b32 s96, 5
    s_cbranch_scc0 L_fx37
    s_waitcnt vmcnt(3)
    s_bitcmp1_b32 s97, 5
    s_cbranch_scc0 L_fx37
    s_waitcnt vmcnt(2)
L_fx37:
    s_xor_b32 s11, s10, 8704
    buffer_load_dwordx4 v[148:151], v249, s[20:23], s11 offen nt
    s_waitcnt vmcnt(4)
    s_bitcmp1_b32 s96, 6
    s_cbranch_scc0 L_fx38
    s_waitcnt vmcnt(3)
    s_bitcmp1_b32 s97, 6
    s_cbranch_scc0 L_fx38
    s_waitcnt vmcnt(2)
L_fx38:
    s_xor_b32 s11, s10, 12288
    buffer_load_dwordx4 v[152:155], v249, s[20:23], s11 offen nt
    s_waitcnt vmcnt(4)
    s_bitcmp1_b32 s96, 7
    s_cbranch_scc0 L_fx39
    s_waitcnt vmcnt(3)
L_fx39:
    s_xor_b32 s11, s10, 12800
    buffer_load_dwordx4 v[156:159], v249, s[20:23], s11 offen nt
    s_waitcnt vmcnt(4)
    s_bitcmp1_b32 s96, 8
    s_cbranch_scc0 L_fx40
    s_waitcnt vmcnt(2)
L_fx40:
    s_xor_b32 s11, s10, 256
    buffer_load_dwordx4 v[160:163], v249, s[20:23], s11 offen nt
    s_waitcnt vmcnt(3)
    s_bitcmp1_b32 s96, 9
    s_cbranch_scc0 L_fx41
    s_waitcnt vmcnt(2)
    s_bitcmp1_b32 s97, 9
    s_cbranch_scc0 L_fx41
    s_waitcnt vmcnt(1)
L_fx41:
    s_xor_b32 s11, s10, 768
    buffer_load_dwordx4 v[164:167], v249, s[20:23], s11 offen nt
    s_waitcnt vmcnt(3)
    s_bitcmp1_b32 s96, 10
    s_cbranch_scc0 L_fx42
    s_waitcnt vmcnt(2)
    s_bitcmp1_b32 s97, 10
    s_cbranch_scc0 L_fx42
    s_waitcnt vmcnt(1)
L_fx42:
    s_xor_b32 s11, s10, 4352
    buffer_load_dwordx4 v[168:171], v249, s[20:23], s11 offen nt
    s_mov_b32 s55, s41
    s_mov_b32 s54, s48
    s_mov_b32 s14, 200000
    buffer_load_dwordx4 v[192:195], v198, s[24:27], s55 offen sc1 nt
    s_waitcnt vmcnt(4)
    s_bitcmp1_b32 s96, 11
    s_cbranch_scc0 L_fx43
    s_waitcnt vmcnt(3)
    s_bitcmp1_b32 s97, 11
    s_cbranch_scc0 L_fx43
    s_waitcnt vmcnt(2)
L_fx43:
    s_xor_b32 s11, s10, 4864
    buffer_load_dwordx4 v[172:175], v249, s[20:23], s11 offen nt
    s_waitcnt vmcnt(4)
    s_bitcmp1_b32 s96, 12
    s_cbranch_scc0 L_fx44
    s_waitcnt vmcnt(3)
    s_bitcmp1_b32 s97, 12
    s_cbranch_scc0 L_fx44
    s_waitcnt vmcnt(2)
L_fx44:
    s_xor_b32 s11, s10, 8448
    buffer_load_dwordx4 v[176:179], v249, s[20:23], s11 offen nt
    s_barrier
    s_waitcnt vmcnt(4)
    s_bitcmp1_b32 s96, 13
    s_cbranch_scc0 L_fx45
    s_waitcnt vmcnt(3)
L_fx45:
    s_xor_b32 s11, s10, 8960
    buffer_load_dwordx4 v[180:183], v249, s[20:23], s11 offen nt
    s_waitcnt vmcnt(3)
L_g0:
    v_xor_b32_sdwa v192, v192, s54 dst_sel:DWORD dst_unused:UNUSED_PAD src0_sel:DWORD src1_sel:BYTE_0
    v_xor_b32_sdwa v193, v193, s54 dst_sel:DWORD dst_unused:UNUSED_PAD src0_sel:DWORD src1_sel:BYTE_1
    v_xor_b32_sdwa v194, v194, s54 dst_sel:DWORD dst_unused:UNUSED_PAD src0_sel:DWORD src1_sel:BYTE_2
    v_xor_b32_sdwa v195, v195, s54 dst_sel:DWORD dst_unused:UNUSED_PAD src0_sel:DWORD src1_sel:BYTE_3
    v_or3_b32 v196, v192, v193, v194
    v_or_b32 v196, v196, v195
    v_cmp_ne_u32_sdwa vcc, v196, 0 src0_sel:BYTE_0 src1_sel:DWORD
    s_and_b64 exec, vcc, vcc
    s_cbranch_scc0 L_g1
    s_xor_b32 s55, s55, s50
    s_xor_b32 s54, s54, s51
    buffer_load_dwordx4 v[192:195], v198, s[24:27], s55 offen sc1 nt
    s_sub_u32 s14, s14, 1
    s_waitcnt vmcnt(0)
    s_cbranch_scc0 L_g0
L_g1:
    s_mov_b64 exec, -1
    v_mov_b32 v196, v192
    s_nop 1
    v_max_f32_dpp v196, v196, v196 quad_perm:[1,0,3,2] row_mask:0xf bank_mask:0xf
    s_nop 1
    v_max_f32_dpp v196, v196, v196 quad_perm:[2,3,0,1] row_mask:0xf bank_mask:0xf
    s_nop 1
    v_max_f32_dpp v196, v196, v196 row_half_mirror row_mask:0xf bank_mask:0xf
    v_mov_b32 v242, v196
    s_nop 1
    v_permlane32_swap_b32 v196, v242
    s_nop 1
    v_max_f32 v196, v196, v242
    v_mov_b32 v242, v196
    s_nop 1
    v_permlane16_swap_b32 v196, v242
    s_nop 1
    v_max_f32 v196, v196, v242
    v_sub_f32 v192, v192, v196
    v_sub_f32 v240, v240, v196
    v_mul_f32 v192, s66, v192
    v_mul_f32 v240, s66, v240
    v_exp_f32 v192, v192
    v_exp_f32 v240, v240
    v_mul_f32 v193, v192, v193
    s_nop 1
    v_add_f32_dpp v193, v193, v193 quad_perm:[1,0,3,2] row_mask:0xf bank_mask:0xf
    s_nop 1
    v_add_f32_dpp v193, v193, v193 quad_perm:[2,3,0,1] row_mask:0xf bank_mask:0xf
    s_nop 1
    v_add_f32_dpp v193, v193, v193 row_half_mirror row_mask:0xf bank_mask:0xf
    v_mov_b32 v242, v193
    s_nop 1
    v_permlane32_swap_b32 v193, v242
    s_nop 1
    v_add_f32 v193, v193, v242
    v_mov_b32 v242, v193
    s_nop 1
    v_permlane16_swap_b32 v193, v242
    s_nop 1
    v_add_f32 v193, v193, v242
    v_rcp_f32 v193, v193
    s_waitcnt vmcnt(4)
    s_bitcmp1_b32 s96, 14
    s_cbranch_scc0 L_fx46
    s_waitcnt vmcnt(2)
    s_bitcmp1_b32 s97, 14
    s_cbranch_scc0 L_fx46
    s_waitcnt vmcnt(1)
L_fx46:
    s_xor_b32 s11, s10, 12544
    buffer_load_dwordx4 v[184:187], v249, s[20:23], s11 offen nt
    v_mul_f32 v240, v240, v193
    v_mul_f32 v224, v224, v240
    v_mul_f32 v225, v225, v240
    v_mul_f32 v226, v226, v240
    v_mul_f32 v227, v227, v240
    v_mul_f32 v228, v228, v240
    v_mul_f32 v229, v229, v240
    v_mul_f32 v230, v230, v240
    v_mul_f32 v231, v231, v240
    v_mul_f32 v232, v232, v240
    v_mul_f32 v233, v233, v240
    v_mul_f32 v234, v234, v240
    v_mul_f32 v235, v235, v240
    v_mul_f32 v236, v236, v240
    v_mul_f32 v237, v237, v240
    v_mul_f32 v238, v238, v240
    v_mul_f32 v239, v239, v240
    v_cvt_pk_bf16_f32 v224, v224, v225
    v_cvt_pk_bf16_f32 v225, v226, v227
    v_cvt_pk_bf16_f32 v226, v228, v229
    v_cvt_pk_bf16_f32 v227, v230, v231
    v_cvt_pk_bf16_f32 v228, v232, v233
    v_cvt_pk_bf16_f32 v229, v234, v235
    v_cvt_pk_bf16_f32 v230, v236, v237
    v_cvt_pk_bf16_f32 v231, v238, v239
    s_mov_b32 vcc_lo, 0x01010101
    s_mov_b32 vcc_hi, 0x01010101
    v_cndmask_b32 v64, 0, v224, vcc
    v_cndmask_b32 v65, 0, v225, vcc
    v_cndmask_b32 v66, 0, v226, vcc
    v_cndmask_b32 v67, 0, v227, vcc
    v_cndmask_b32 v96, 0, v228, vcc
    v_cndmask_b32 v97, 0, v229, vcc
    v_cndmask_b32 v98, 0, v230, vcc
    v_cndmask_b32 v99, 0, v231, vcc
    s_lshl_b64 vcc, vcc, 1
    v_cndmask_b32 v68, 0, v224, vcc
    v_cndmask_b32 v69, 0, v225, vcc
    v_cndmask_b32 v70, 0, v226, vcc
    v_cndmask_b32 v71, 0, v227, vcc
    v_cndmask_b32 v100, 0, v228, vcc
    v_cndmask_b32 v101, 0, v229, vcc
    v_cndmask_b32 v102, 0, v230, vcc
    v_cndmask_b32 v103, 0, v231, vcc
    s_lshl_b64 vcc, vcc, 1
    v_cndmask_b32 v72, 0, v224, vcc
    v_cndmask_b32 v73, 0, v225, vcc
    v_cndmask_b32 v74, 0, v226, vcc
    v_cndmask_b32 v75, 0, v227, vcc
    v_cndmask_b32 v104, 0, v228, vcc
    v_cndmask_b32 v105, 0, v229, vcc
    v_cndmask_b32 v106, 0, v230, vcc
    v_cndmask_b32 v107, 0, v231, vcc
    s_lshl_b64 vcc, vcc, 1
    v_cndmask_b32 v76, 0, v224, vcc
    v_cndmask_b32 v77, 0, v225, vcc
    v_cndmask_b32 v78, 0, v226, vcc
    v_cndmask_b32 v79, 0, v227, vcc
    v_cndmask_b32 v108, 0, v228, vcc
    v_cndmask_b32 v109, 0, v229, vcc
    v_cndmask_b32 v110, 0, v230, vcc
    v_cndmask_b32 v111, 0, v231, vcc
    s_lshl_b64 vcc, vcc, 1
    v_cndmask_b32 v80, 0, v224, vcc
    v_cndmask_b32 v81, 0, v225, vcc
    v_cndmask_b32 v82, 0, v226, vcc
    v_cndmask_b32 v83, 0, v227, vcc
    v_cndmask_b32 v112, 0, v228, vcc
    v_cndmask_b32 v113, 0, v229, vcc
    v_cndmask_b32 v114, 0, v230, vcc
    v_cndmask_b32 v115, 0, v231, vcc
    s_lshl_b64 vcc, vcc, 1
    s_waitcnt vmcnt(3)
    s_bitcmp1_b32 s96, 15
    s_cbranch_scc0 L_fx47
    s_waitcnt vmcnt(2)
    s_bitcmp1_b32 s97, 15
    s_cbranch_scc0 L_fx47
    s_waitcnt vmcnt(1)
L_fx47:
    s_xor_b32 s11, s10, 13056
    buffer_load_dwordx4 v[188:191], v249, s[20:23], s11 offen nt
    v_cndmask_b32 v84, 0, v224, vcc
    v_cndmask_b32 v85, 0, v225, vcc
    v_cndmask_b32 v86, 0, v226, vcc
    v_cndmask_b32 v87, 0, v227, vcc
    v_cndmask_b32 v116, 0, v228, vcc
    v_cndmask_b32 v117, 0, v229, vcc
    v_cndmask_b32 v118, 0, v230, vcc
    v_cndmask_b32 v119, 0, v231, vcc
    s_lshl_b64 vcc, vcc, 1
    v_cndmask_b32 v88, 0, v224, vcc
    v_cndmask_b32 v89, 0, v225, vcc
    v_cndmask_b32 v90, 0, v226, vcc
    v_cndmask_b32 v91, 0, v227, vcc
    v_cndmask_b32 v120, 0, v228, vcc
    v_cndmask_b32 v121, 0, v229, vcc
    v_cndmask_b32 v122, 0, v230, vcc
    v_cndmask_b32 v123, 0, v231, vcc
    s_lshl_b64 vcc, vcc, 1
    v_cndmask_b32 v92, 0, v224, vcc
    v_cndmask_b32 v93, 0, v225, vcc
    v_cndmask_b32 v94, 0, v226, vcc
    v_cndmask_b32 v95, 0, v227, vcc
    v_cndmask_b32 v124, 0, v228, vcc
    v_cndmask_b32 v125, 0, v229, vcc
    v_cndmask_b32 v126, 0, v230, vcc
    v_cndmask_b32 v127, 0, v231, vcc
    v_perm_b32 v192, v132, v128, s64
    v_perm_b32 v193, v140, v136, s64
    v_perm_b32 v194, v148, v144, s64
    v_perm_b32 v195, v156, v152, s64
    v_perm_b32 v196, v132, v128, s65
    v_perm_b32 v197, v140, v136, s65
    v_perm_b32 v198, v148, v144, s65
    v_perm_b32 v199, v156, v152, s65
    v_mfma_f32_16x16x32_bf16 v[240:243], v[64:67], v[192:195], 0
    v_perm_b32 v200, v133, v129, s64
    v_perm_b32 v201, v141, v137, s64
    v_perm_b32 v202, v149, v145, s64
    v_perm_b32 v203, v157, v153, s64
    v_mfma_f32_16x16x32_bf16 v[240:243], v[68:71], v[196:199], v[240:243]
    v_perm_b32 v204, v133, v129, s65
    v_perm_b32 v205, v141, v137, s65
    v_perm_b32 v206, v149, v145, s65
    v_perm_b32 v207, v157, v153, s65
    v_mfma_f32_16x16x32_bf16 v[240:243], v[72:75], v[200:203], v[240:243]
    v_perm_b32 v208, v134, v130, s64
    v_perm_b32 v209, v142, v138, s64
    v_perm_b32 v210, v150, v146, s64
    v_perm_b32 v211, v158, v154, s64
    v_mfma_f32_16x16x32_bf16 v[240:243], v[76:79], v[204:207], v[240:243]
    v_perm_b32 v212, v134, v130, s65
    v_perm_b32 v213, v142, v138, s65
    v_perm_b32 v214, v150, v146, s65
    v_perm_b32 v215, v158, v154, s65
    v_mfma_f32_16x16x32_bf16 v[240:243], v[80:83], v[208:211], v[240:243]
    v_perm_b32 v216, v135, v131, s64
    v_perm_b32 v217, v143, v139, s64
    v_perm_b32 v218, v151, v147, s64
    v_perm_b32 v219, v159, v155, s64
    v_mfma_f32_16x16x32_bf16 v[240:243], v[84:87], v[212:215], v[240:243]
    v_perm_b32 v220, v135, v131, s65
    v_perm_b32 v221, v143, v139, s65
    v_perm_b32 v222, v151, v147, s65
    v_perm_b32 v223, v159, v155, s65
    v_mfma_f32_16x16x32_bf16 v[240:243], v[88:91], v[216:219], v[240:243]
    s_nop 0
    v_mfma_f32_16x16x32_bf16 v[240:243], v[92:95], v[220:223], v[240:243]
    s_waitcnt vmcnt(3)
    s_bitcmp1_b32 s96, 16
    s_cbranch_scc0 L_fx48
    s_waitcnt vmcnt(2)
    s_bitcmp1_b32 s97, 16
    s_cbranch_scc0 L_fx48
    s_waitcnt vmcnt(1)
L_fx48:
    s_xor_b32 s11, s10, 16384
    buffer_load_dwordx4 v[0:3], v249, s[20:23], s11 offen nt
    s_waitcnt vmcnt(3)
    s_bitcmp1_b32 s96, 17
    s_cbranch_scc0 L_fx49
    s_waitcnt vmcnt(2)
L_fx49:
    s_xor_b32 s11, s10, 16896
    buffer_load_dwordx4 v[4:7], v249, s[20:23], s11 offen nt
    s_waitcnt vmcnt(3)
    s_bitcmp1_b32 s96, 18
    s_cbranch_scc0 L_fx50
    s_waitcnt vmcnt(2)
L_fx50:
    s_xor_b32 s11, s10, 20480
    buffer_load_dwordx4 v[8:11], v249, s[20:23], s11 offen nt
    s_barrier
    s_lshl_b32 s99, s4, 7
    s_add_u32 s99, s99, 5120
    s_lshl_b64 exec, 1, s5
    s_cmp_lg_u32 s3, 0
    v_lshlrev_b32 v252, 2, v250
    s_cbranch_scc1 L_rk0
    buffer_store_dword v251, v252, s[24:27], s99 offen
L_rk0:
    s_mov_b32 exec_lo, -1
    s_mov_b32 exec_hi, 0
    v_lshlrev_b32 v252, 2, v250
    buffer_load_dword v255, v252, s[24:27], s99 offen sc1 nt
    s_mov_b64 exec, -1
    s_waitcnt vmcnt(4)
    s_bitcmp1_b32 s96, 19
    s_cbranch_scc0 L_fx51
    s_waitcnt vmcnt(3)
    s_bitcmp1_b32 s97, 19
    s_cbranch_scc0 L_fx51
    s_waitcnt vmcnt(2)
L_fx51:
    s_xor_b32 s11, s10, 20992
    buffer_load_dwordx4 v[12:15], v249, s[20:23], s11 offen nt
    v_perm_b32 v192, v164, v160, s64
    v_perm_b32 v193, v172, v168, s64
    v_perm_b32 v194, v180, v176, s64
    v_perm_b32 v195, v188, v184, s64
    v_perm_b32 v196, v164, v160, s65
    v_perm_b32 v197, v172, v168, s65
    v_perm_b32 v198, v180, v176, s65
    v_perm_b32 v199, v188, v184, s65
    v_mfma_f32_16x16x32_bf16 v[244:247], v[64:67], v[192:195], 0
    v_perm_b32 v200, v165, v161, s64
    v_perm_b32 v201, v173, v169, s64
    v_perm_b32 v202, v181, v177, s64
    v_perm_b32 v203, v189, v185, s64
    v_mfma_f32_16x16x32_bf16 v[244:247], v[68:71], v[196:199], v[244:247]
    v_perm_b32 v204, v165, v161, s65
    v_perm_b32 v205, v173, v169, s65
    v_perm_b32 v206, v181, v177, s65
    v_perm_b32 v207, v189, v185, s65
    v_mfma_f32_16x16x32_bf16 v[244:247], v[72:75], v[200:203], v[244:247]
    v_perm_b32 v208, v166, v162, s64
    v_perm_b32 v209, v174, v170, s64
    v_perm_b32 v210, v182, v178, s64
    v_perm_b32 v211, v190, v186, s64
    v_mfma_f32_16x16x32_bf16 v[244:247], v[76:79], v[204:207], v[244:247]
    v_perm_b32 v212, v166, v162, s65
    v_perm_b32 v213, v174, v170, s65
    v_perm_b32 v214, v182, v178, s65
    v_perm_b32 v215, v190, v186, s65
    v_mfma_f32_16x16x32_bf16 v[244:247], v[80:83], v[208:211], v[244:247]
    v_perm_b32 v216, v167, v163, s64
    v_perm_b32 v217, v175, v171, s64
    v_perm_b32 v218, v183, v179, s64
    v_perm_b32 v219, v191, v187, s64
    v_mfma_f32_16x16x32_bf16 v[244:247], v[84:87], v[212:215], v[244:247]
    v_perm_b32 v220, v167, v163, s65
    v_perm_b32 v221, v175, v171, s65
    v_perm_b32 v222, v183, v179, s65
    v_perm_b32 v223, v191, v187, s65
    v_mfma_f32_16x16x32_bf16 v[244:247], v[88:91], v[216:219], v[244:247]
    s_nop 0
    v_mfma_f32_16x16x32_bf16 v[244:247], v[92:95], v[220:223], v[244:247]
    s_waitcnt vmcnt(4)
    s_bitcmp1_b32 s96, 20
    s_cbranch_scc0 L_fx52
    s_waitcnt vmcnt(3)
L_fx52:
    s_xor_b32 s11, s10, 24576
    buffer_load_dwordx4 v[16:19], v249, s[20:23], s11 offen nt
    s_waitcnt vmcnt(2)
    v_cmp_eq_u32 s[96:97], v255, v251
    s_nop 0
    s_bcnt1_i32_b32 s99, s96
    s_add_u32 s99, s99, s101
    s_mov_b32 s96, 0x7e00000
    s_mov_b32 s97, 0x7e00000
    s_mov_b32 s98, 0x4a00000
    s_cmp_ge_u32 s99, 19
    s_cselect_b32 s98, 0x0, s98
    s_cmp_ge_u32 s99, 31
    s_cselect_b32 s97, 0x0, s97
    s_cmp_ge_u32 s99, 38
    s_cselect_b32 s96, 0x0, s96
    v_lshrrev_b32 v235, 2, v253
    v_and_b32 v236, 3, v253
    v_lshlrev_b32 v236, 3, v236
    v_lshl_add_u32 v235, v235, 7, v236
    s_and_b32 s12, s3, 1
    s_lshl_b32 s12, s12, 6
    v_add_u32 v235, s12, v235
    v_lshl_add_u32 v236, v254, 9, v235
    v_lshl_add_u32 v235, v254, 10, v235
    v_lshrrev_b32 v236, 3, v250
    v_and_b32 v239, 7, v250
    v_lshlrev_b32 v239, 4, v239
    s_movk_i32 s12, 7168
    v_mad_u32_u24 v239, v236, s12, v239
    s_lshl_b32 s12, s3, 11
    s_add_u32 s12, s12, 32768
    s_and_b32 s13, s10, 0x100
    s_lshl_b32 s13, s13, 1
    s_add_u32 s12, s12, s13
    v_lshlrev_b32 v227, 4, v250
    v_and_b32 v248, 0x200, v227
    v_add3_u32 v224, v227, v248, s12
    v_xor_b32 v225, 0x200, v224
    v_and_b32 v233, 3, v250
    v_lshrrev_b32 v234, 2, v250
    s_and_b32 s12, s3, 1
    s_lshr_b32 s13, s3, 1
    s_lshl_b32 s11, s12, 10
    s_lshl_b32 s14, s13, 8
    s_add_u32 s11, s11, s14
    s_add_u32 s11, s11, 32768
    v_lshlrev_b32 v236, 4, v253
    v_lshl_add_u32 v226, v254, 12, v236
    v_add_u32 v226, s11, v226
    v_lshlrev_b32 v236, 2, v250
    s_lshl_b32 s11, s8, 3
    s_add_u32 s11, s11, s3
    s_lshl_b32 s11, s11, 2
    s_add_u32 s11, s11, s7
    s_lshl_b32 s11, s11, 8
    s_add_u32 s42, s11, 1179648
    s_lshl_b32 s11, s3, 5
    s_add_u32 s11, s11, s68
    s_lshl_b32 s11, s11, 11
    s_add_u32 s43, s11, 1179648
    v_lshrrev_b32 v248, 1, v253
    v_xor_b32 v228, s3, v248
    v_lshlrev_b32 v228, 4, v228
    v_lshl_add_u32 v228, v248, 7, v228
    v_and_b32 v248, 1, v253
    v_lshl_add_u32 v228, v248, 3, v228
    v_and_b32 v248, 1, v254
    v_lshl_add_u32 v228, v248, 2, v228
    v_lshrrev_b32 v248, 1, v254
    v_lshl_add_u32 v228, v248, 10, v228
    v_and_b32 v229, 7, v253
    v_xor_b32 v229, v229, v254
    v_lshlrev_b32 v229, 4, v229
    v_lshl_add_u32 v229, v254, 7, v229
    v_xor_b32 v237, 64, v229
    s_lshl_b32 s11, s6, 1
    s_add_u32 s11, s11, s3
    s_lshl_b32 s11, s11, 6
    s_add_u32 s11, s11, s68
    s_lshl_b32 s11, s11, 9
    s_add_u32 s11, s11, 655360
    v_and_b32 v230, 7, v253
    v_lshlrev_b32 v230, 6, v230
    v_and_b32 v248, 8, v253
    v_lshl_add_u32 v230, v248, 11, v230
    v_lshl_add_u32 v230, v254, 4, v230
    v_add_u32 v230, s11, v230
    s_lshl_b32 s14, s68, 14
    s_lshl_b32 s12, s6, 6
    s_add_u32 s14, s14, s12
    s_add_u32 s14, s14, 655360
    v_lshlrev_b32 v231, 10, v234
    v_lshl_add_u32 v231, v233, 4, v231
    v_add_u32 v231, s14, v231
    s_mov_b32 s44, 512
    s_mul_i32 s12, s6, 896
    s_lshl_b32 s13, s68, 5
    s_add_u32 s12, s12, s13
    v_lshl_add_u32 v232, v233, 2, v254
    v_lshlrev_b32 v232, 1, v232
    v_add_u32 v232, s12, v232
    s_bitcmp1_b32 s96, 21
    s_cbranch_scc0 L_fx53
    s_waitcnt vmcnt(4)
    s_bitcmp1_b32 s97, 21
    s_cbranch_scc0 L_fx53
    s_waitcnt vmcnt(3)
    s_bitcmp1_b32 s98, 21
    s_cbranch_scc0 L_fx53
    s_waitcnt vmcnt(1)
L_fx53:
    s_xor_b32 s11, s10, 25088
    buffer_load_dwordx4 v[20:23], v249, s[20:23], s11 offen nt
    s_waitcnt vmcnt(5)
    s_bitcmp1_b32 s96, 22
    s_cbranch_scc0 L_fx54
    s_waitcnt vmcnt(4)
    s_bitcmp1_b32 s97, 22
    s_cbranch_scc0 L_fx54
    s_waitcnt vmcnt(2)
L_fx54:
    s_xor_b32 s11, s10, 28672
    buffer_load_dwordx4 v[24:27], v249, s[20:23], s11 offen nt
    s_waitcnt vmcnt(5)
    s_bitcmp1_b32 s96, 23
    s_cbranch_scc0 L_fx55
    s_waitcnt vmcnt(3)
    s_bitcmp1_b32 s97, 23
    s_cbranch_scc0 L_fx55
    s_waitcnt vmcnt(2)
    s_bitcmp1_b32 s98, 23
    s_cbranch_scc0 L_fx55
    s_waitcnt vmcnt(1)
L_fx55:
    s_xor_b32 s11, s10, 29184
    buffer_load_dwordx4 v[28:31], v249, s[20:23], s11 offen nt
    s_waitcnt vmcnt(4)
    s_bitcmp1_b32 s96, 24
    s_cbranch_scc0 L_fx56
    s_waitcnt vmcnt(3)
    s_bitcmp1_b32 s97, 24
    s_cbranch_scc0 L_fx56
    s_waitcnt vmcnt(2)
L_fx56:
    s_xor_b32 s11, s10, 16640
    buffer_load_dwordx4 v[32:35], v249, s[20:23], s11 offen nt
    s_barrier
    s_lshl_b32 s99, s4, 7
    s_add_u32 s99, s99, 6144
    s_lshl_b64 exec, 1, s5
    s_cmp_lg_u32 s3, 0
    v_lshlrev_b32 v252, 2, v250
    s_cbranch_scc1 L_rk1
    buffer_store_dword v251, v252, s[24:27], s99 offen
L_rk1:
    s_mov_b32 exec_lo, -1
    s_mov_b32 exec_hi, 0
    v_lshlrev_b32 v252, 2, v250
    buffer_load_dword v255, v252, s[24:27], s99 offen sc1 nt
    s_mov_b64 exec, -1
    s_waitcnt vmcnt(5)
    s_bitcmp1_b32 s96, 25
    s_cbranch_scc0 L_fx57
    s_waitcnt vmcnt(4)
    s_bitcmp1_b32 s97, 25
    s_cbranch_scc0 L_fx57
    s_waitcnt vmcnt(3)
L_fx57:
    s_xor_b32 s11, s10, 17152
    buffer_load_dwordx4 v[36:39], v249, s[20:23], s11 offen nt
    s_waitcnt vmcnt(5)
    s_bitcmp1_b32 s96, 26
    s_cbranch_scc0 L_fx58
    s_waitcnt vmcnt(4)
    s_bitcmp1_b32 s97, 26
    s_cbranch_scc0 L_fx58
    s_waitcnt vmcnt(3)
    s_bitcmp1_b32 s98, 26
    s_cbranch_scc0 L_fx58
    s_waitcnt vmcnt(2)
L_fx58:
    s_xor_b32 s11, s10, 20736
    buffer_load_dwordx4 v[40:43], v249, s[20:23], s11 offen nt
    s_waitcnt vmcnt(2)
    v_cmp_eq_u32 s[96:97], v255, v251
    s_nop 0
    s_bcnt1_i32_b32 s99, s96
    s_add_u32 s99, s99, s101
    s_mov_b32 s96, 0xf8000000
    s_mov_b32 s97, 0xf8000000
    s_cmp_ge_u32 s99, 23
    s_cselect_b32 s97, 0x0, s97
    s_cmp_ge_u32 s99, 33
    s_cselect_b32 s96, 0x0, s96
    s_bitcmp1_b32 s96, 27
    s_cbranch_scc0 L_fx59
    s_waitcnt vmcnt(4)
    s_bitcmp1_b32 s97, 27
    s_cbranch_scc0 L_fx59
    s_waitcnt vmcnt(3)
L_fx59:
    s_xor_b32 s11, s10, 21248
    buffer_load_dwordx4 v[44:47], v249, s[20:23], s11 offen nt
    s_waitcnt vmcnt(6)
    s_bitcmp1_b32 s96, 28
    s_cbranch_scc0 L_fx60
    s_waitcnt vmcnt(4)
    s_bitcmp1_b32 s97, 28
    s_cbranch_scc0 L_fx60
    s_waitcnt vmcnt(2)
L_fx60:
    s_xor_b32 s11, s10, 24832
    buffer_load_dwordx4 v[48:51], v249, s[20:23], s11 offen nt
    s_waitcnt vmcnt(6)
    s_bitcmp1_b32 s96, 29
    s_cbranch_scc0 L_fx61
    s_waitcnt vmcnt(3)
    s_bitcmp1_b32 s97, 29
    s_cbranch_scc0 L_fx61
    s_waitcnt vmcnt(2)
L_fx61:
    s_xor_b32 s11, s10, 25344
    buffer_load_dwordx4 v[52:55], v249, s[20:23], s11 offen nt
    v_perm_b32 v192, v4, v0, s64
    v_perm_b32 v193, v12, v8, s64
    v_perm_b32 v194, v20, v16, s64
    v_perm_b32 v195, v28, v24, s64
    v_perm_b32 v196, v4, v0, s65
    v_perm_b32 v197, v12, v8, s65
    v_perm_b32 v198, v20, v16, s65
    v_perm_b32 v199, v28, v24, s65
    v_mfma_f32_16x16x32_bf16 v[240:243], v[96:99], v[192:195], v[240:243]
    v_perm_b32 v200, v5, v1, s64
    v_perm_b32 v201, v13, v9, s64
    v_perm_b32 v202, v21, v17, s64
    v_perm_b32 v203, v29, v25, s64
    v_mfma_f32_16x16x32_bf16 v[240:243], v[100:103], v[196:199], v[240:243]
    v_perm_b32 v204, v5, v1, s65
    v_perm_b32 v205, v13, v9, s65
    v_perm_b32 v206, v21, v17, s65
    v_perm_b32 v207, v29, v25, s65
    v_mfma_f32_16x16x32_bf16 v[240:243], v[104:107], v[200:203], v[240:243]
    v_perm_b32 v208, v6, v2, s64
    v_perm_b32 v209, v14, v10, s64
    v_perm_b32 v210, v22, v18, s64
    v_perm_b32 v211, v30, v26, s64
    v_mfma_f32_16x16x32_bf16 v[240:243], v[108:111], v[204:207], v[240:243]
    v_perm_b32 v212, v6, v2, s65
    v_perm_b32 v213, v14, v10, s65
    v_perm_b32 v214, v22, v18, s65
    v_perm_b32 v215, v30, v26, s65
    v_mfma_f32_16x16x32_bf16 v[240:243], v[112:115], v[208:211], v[240:243]
    v_perm_b32 v216, v7, v3, s64
    v_perm_b32 v217, v15, v11, s64
    v_perm_b32 v218, v23, v19, s64
    v_perm_b32 v219, v31, v27, s64
    v_mfma_f32_16x16x32_bf16 v[240:243], v[116:119], v[212:215], v[240:243]
    v_perm_b32 v220, v7, v3, s65
    v_perm_b32 v221, v15, v11, s65
    v_perm_b32 v222, v23, v19, s65
    v_perm_b32 v223, v31, v27, s65
    v_mfma_f32_16x16x32_bf16 v[240:243], v[120:123], v[216:219], v[240:243]
    s_nop 0
    v_mfma_f32_16x16x32_bf16 v[240:243], v[124:127], v[220:223], v[240:243]
    s_waitcnt vmcnt(6)
    s_bitcmp1_b32 s96, 30
    s_cbranch_scc0 L_fx62
    s_waitcnt vmcnt(3)
    s_bitcmp1_b32 s97, 30
    s_cbranch_scc0 L_fx62
    s_waitcnt vmcnt(2)
L_fx62:
    s_xor_b32 s11, s10, 28928
    buffer_load_dwordx4 v[56:59], v249, s[20:23], s11 offen nt
    s_waitcnt vmcnt(5)
    s_bitcmp1_b32 s96, 31
    s_cbranch_scc0 L_fx63
    s_waitcnt vmcnt(3)
    s_bitcmp1_b32 s97, 31
    s_cbranch_scc0 L_fx63
    s_waitcnt vmcnt(2)
L_fx63:
    s_xor_b32 s11, s10, 29440
    buffer_load_dwordx4 v[60:63], v249, s[20:23], s11 offen nt
    s_waitcnt vmcnt(6)
    v_perm_b32 v192, v36, v32, s64
    v_perm_b32 v196, v36, v32, s65
    v_perm_b32 v200, v37, v33, s64
    v_perm_b32 v204, v37, v33, s65
    v_perm_b32 v208, v38, v34, s64
    v_perm_b32 v212, v38, v34, s65
    v_perm_b32 v216, v39, v35, s64
    v_perm_b32 v220, v39, v35, s65
    s_waitcnt vmcnt(4)
    v_perm_b32 v193, v44, v40, s64
    v_perm_b32 v197, v44, v40, s65
    v_perm_b32 v201, v45, v41, s64
    v_perm_b32 v205, v45, v41, s65
    v_perm_b32 v209, v46, v42, s64
    v_perm_b32 v213, v46, v42, s65
    v_perm_b32 v217, v47, v43, s64
    v_perm_b32 v221, v47, v43, s65
    ds_write_b128 v224, v[240:243]
    s_waitcnt vmcnt(4)
    s_bitcmp1_b32 s96, 31
    s_cbranch_scc0 L_wq0
    s_waitcnt vmcnt(3)
    s_bitcmp1_b32 s97, 31
    s_cbranch_scc0 L_wq0
    s_waitcnt vmcnt(2)
L_wq0:
    s_lshl_b32 s12, s3, 11
    s_add_u32 m0, s12, 16384
    s_mov_b32 s12, 0
    buffer_load_dwordx4 v239, s[28:31], s12 offen nt lds
    s_waitcnt vmcnt(4)
    s_bitcmp1_b32 s96, 31
    s_cbranch_scc0 L_wq1
    s_waitcnt vmcnt(2)
    s_bitcmp1_b32 s97, 31
    s_cbranch_scc0 L_wq1
    s_waitcnt vmcnt(2)
L_wq1:
    s_lshl_b32 s12, s3, 11
    s_add_u32 m0, s12, 17408
    s_mov_b32 s12, 57344
    buffer_load_dwordx4 v239, s[28:31], s12 offen nt lds
    s_waitcnt vmcnt(4)
    v_perm_b32 v194, v52, v48, s64
    v_perm_b32 v198, v52, v48, s65
    v_perm_b32 v202, v53, v49, s64
    v_perm_b32 v206, v53, v49, s65
    v_perm_b32 v210, v54, v50, s64
    v_perm_b32 v214, v54, v50, s65
    v_perm_b32 v218, v55, v51, s64
    v_perm_b32 v222, v55, v51, s65
    s_mov_b32 s14, 200000
    s_xor_b32 s54, s48, 0x08080808
    s_lshl_b32 s50, s50, 1
    v_lshlrev_b32 v248, 3, v233
    v_lshrrev_b32 v238, v248, s54
    v_mov_b32 v251, s15
    s_cmp_eq_u32 s6, 7
    s_waitcnt vmcnt(2)
    v_perm_b32 v195, v60, v56, s64
    v_perm_b32 v199, v60, v56, s65
    v_perm_b32 v203, v61, v57, s64
    v_mfma_f32_16x16x32_bf16 v[244:247], v[96:99], v[192:195], v[244:247]
    v_perm_b32 v207, v61, v57, s65
    v_mfma_f32_16x16x32_bf16 v[244:247], v[100:103], v[196:199], v[244:247]
    v_perm_b32 v211, v62, v58, s64
    v_mfma_f32_16x16x32_bf16 v[244:247], v[104:107], v[200:203], v[244:247]
    v_perm_b32 v215, v62, v58, s65
    v_mfma_f32_16x16x32_bf16 v[244:247], v[108:111], v[204:207], v[244:247]
    v_perm_b32 v219, v63, v59, s64
    v_mfma_f32_16x16x32_bf16 v[244:247], v[112:115], v[208:211], v[244:247]
    v_perm_b32 v223, v63, v59, s65
    v_mfma_f32_16x16x32_bf16 v[244:247], v[116:119], v[212:215], v[244:247]
    v_mfma_f32_16x16x32_bf16 v[244:247], v[120:123], v[216:219], v[244:247]
    v_mfma_f32_16x16x32_bf16 v[244:247], v[124:127], v[220:223], v[244:247]
    buffer_load_dwordx4 v[8:11], v227, s[24:27], s43 offen sc1 nt
    buffer_load_dwordx4 v[12:15], v227, s[24:27], s43 offen offset:1024 sc1 nt
    s_nop 5
    ds_write_b128 v225, v[244:247]
    s_waitcnt lgkmcnt(0)
    s_barrier
    ds_read_b128 v[0:3], v226
    ds_read_b128 v[4:7], v226 offset:2048
    s_waitcnt lgkmcnt(0)
    v_add_f32 v0, v0, v4
    v_add_f32 v2, v2, v6
    v_add_f32 v1, v1, v5
    v_add_f32 v3, v3, v7
    v_permlane32_swap_b32 v0, v2
    s_nop 0
    v_permlane32_swap_b32 v1, v3
    v_add_f32 v0, v0, v2
    v_add_f32 v1, v1, v3
    s_nop 1
    v_permlane16_swap_b32 v0, v1
    s_nop 0
    v_add_f32 v0, v0, v1
    v_bfi_b32 v0, s69, v238, v0
    buffer_store_dword v0, v236, s[24:27], s42 offen
    s_cbranch_scc1 L_b7
    s_cmp_lg_u32 s50, 0
    s_cbranch_scc1 L_h1B
L_h1R:
    s_waitcnt vmcnt(3)
L_woCR:
    s_cmp_ge_u32 s3, 2
    s_barrier
    s_cbranch_scc1 L_wa
    buffer_load_dwordx4 v[8:11], v227, s[24:27], s43 offen sc1 nt
    buffer_load_dwordx4 v[12:15], v227, s[24:27], s43 offen offset:1024 sc1 nt
    ds_read_b64_tr_b16 v[128:129], v235 offset:16384
    ds_read_b64_tr_b16 v[130:131], v235 offset:16896
    ds_read_b64_tr_b16 v[132:133], v235 offset:20480
    ds_read_b64_tr_b16 v[134:135], v235 offset:20992
    ds_read_b64_tr_b16 v[136:137], v235 offset:24576
    ds_read_b64_tr_b16 v[138:139], v235 offset:25088
    ds_read_b64_tr_b16 v[140:141], v235 offset:28672
    ds_read_b64_tr_b16 v[142:143], v235 offset:29184
    ds_read_b64_tr_b16 v[144:145], v235 offset:16416
    ds_read_b64_tr_b16 v[146:147], v235 offset:16928
    ds_read_b64_tr_b16 v[148:149], v235 offset:20512
    ds_read_b64_tr_b16 v[150:151], v235 offset:21024
    ds_read_b64_tr_b16 v[152:153], v235 offset:24608
    ds_read_b64_tr_b16 v[154:155], v235 offset:25120
    ds_read_b64_tr_b16 v[156:157], v235 offset:28704
    ds_read_b64_tr_b16 v[158:159], v235 offset:29216
    s_waitcnt vmcnt(0)
L_wa:
    s_waitcnt vmcnt(1)
L_h0:
    v_xor_b32_sdwa v8, v8, s54 dst_sel:DWORD dst_unused:UNUSED_PAD src0_sel:DWORD src1_sel:BYTE_0
    v_xor_b32_sdwa v9, v9, s54 dst_sel:DWORD dst_unused:UNUSED_PAD src0_sel:DWORD src1_sel:BYTE_1
    v_xor_b32_sdwa v10, v10, s54 dst_sel:DWORD dst_unused:UNUSED_PAD src0_sel:DWORD src1_sel:BYTE_2
    v_xor_b32_sdwa v11, v11, s54 dst_sel:DWORD dst_unused:UNUSED_PAD src0_sel:DWORD src1_sel:BYTE_3
    v_xor_b32_sdwa v12, v12, s54 dst_sel:DWORD dst_unused:UNUSED_PAD src0_sel:DWORD src1_sel:BYTE_0
    v_xor_b32_sdwa v13, v13, s54 dst_sel:DWORD dst_unused:UNUSED_PAD src0_sel:DWORD src1_sel:BYTE_1
    v_xor_b32_sdwa v14, v14, s54 dst_sel:DWORD dst_unused:UNUSED_PAD src0_sel:DWORD src1_sel:BYTE_2
    v_xor_b32_sdwa v15, v15, s54 dst_sel:DWORD dst_unused:UNUSED_PAD src0_sel:DWORD src1_sel:BYTE_3
    v_or3_b32 v16, v8, v9, v10
    v_or3_b32 v16, v16, v11, v12
    v_or3_b32 v16, v16, v13, v14
    v_or_b32 v16, v16, v15
    v_cmp_ne_u32_sdwa vcc, v16, 0 src0_sel:BYTE_0 src1_sel:DWORD
    s_and_b64 exec, vcc, vcc
    s_cbranch_scc0 L_h1
    s_xor_b32 s43, s43, s50
    s_xor_b32 s54, s54, s51
    buffer_load_dwordx4 v[8:11], v227, s[24:27], s43 offen sc1 nt
    buffer_load_dwordx4 v[12:15], v227, s[24:27], s43 offen offset:1024 sc1 nt
    s_sub_u32 s14, s14, 1
    s_waitcnt vmcnt(0)
    s_cbranch_scc0 L_h0
L_h1:
    s_mov_b64 exec, -1
    s_cmp_ge_u32 s3, 2
    v_permlane32_swap_b32 v8, v12
    v_permlane32_swap_b32 v9, v13
    v_permlane32_swap_b32 v10, v14
    v_permlane32_swap_b32 v11, v15
    v_add_f32 v8, v8, v12
    v_add_f32 v10, v10, v14
    v_add_f32 v9, v9, v13
    v_add_f32 v11, v11, v15
    v_permlane16_swap_b32 v8, v10
    s_nop 0
    v_permlane16_swap_b32 v9, v11
    v_add_f32 v8, v8, v10
    v_add_f32 v9, v9, v11
    v_cvt_pk_bf16_f32 v8, v8, v9
    ds_write_b32 v228, v8 offset:49152
    s_waitcnt lgkmcnt(0)
    s_barrier
    s_cbranch_scc1 L_role
    ds_read_b128 v[24:27], v229 offset:49152
    ds_read_b128 v[28:31], v237 offset:49664
    ds_read_b128 v[32:35], v229 offset:50176
    ds_read_b128 v[36:39], v237 offset:50688
    s_waitcnt lgkmcnt(3)
    v_mfma_f32_16x16x32_bf16 v[44:47], v[144:147], v[24:27], 0
    v_mfma_f32_16x16x32_bf16 v[40:43], v[128:131], v[24:27], 0
    s_waitcnt lgkmcnt(2)
    v_mfma_f32_16x16x32_bf16 v[44:47], v[148:151], v[28:31], v[44:47]
    v_mfma_f32_16x16x32_bf16 v[40:43], v[132:135], v[28:31], v[40:43]
    s_waitcnt lgkmcnt(1)
    v_mfma_f32_16x16x32_bf16 v[44:47], v[152:155], v[32:35], v[44:47]
    v_mfma_f32_16x16x32_bf16 v[40:43], v[136:139], v[32:35], v[40:43]
    s_waitcnt lgkmcnt(0)
    v_mfma_f32_16x16x32_bf16 v[44:47], v[156:159], v[36:39], v[44:47]
    v_mfma_f32_16x16x32_bf16 v[40:43], v[140:143], v[36:39], v[40:43]
    s_mov_b32 vcc_lo, 0x00ff00ff
    s_mov_b32 vcc_hi, 0x00ff00ff
    s_nop 4
    v_perm_b32 v44, v44, v251, s76
    v_perm_b32 v45, v45, v251, s77
    v_perm_b32 v46, v46, v251, s78
    v_perm_b32 v47, v47, v251, s79
    s_mov_b64 exec, vcc
    v_perm_b32 v44, v40, v251, s76
    v_perm_b32 v45, v41, v251, s77
    v_perm_b32 v46, v42, v251, s78
    v_perm_b32 v47, v43, v251, s79
    s_mov_b64 exec, -1
    buffer_store_dwordx4 v[44:47], v230, s[24:27], 0 offen sc1
    s_mov_b64 exec, -1
    s_cmp_eq_u32 s3, 1
    s_waitcnt vmcnt(0)
    s_cbranch_scc1 L_role1
    s_endpgm
L_h1B:
    s_xor_b32 s12, s54, s49
    s_add_u32 s11, s42, s50
    v_lshrrev_b32 v238, v248, s12
    v_bfi_b32 v1, s69, v238, v0
    buffer_store_dword v1, v236, s[24:27], s11 offen sc1
    s_branch L_h1R
L_b7:
    s_waitcnt vmcnt(3)
    s_cmp_eq_u32 s50, 0
    s_cbranch_scc1 L_role
    s_xor_b32 s12, s54, s49
    s_add_u32 s11, s42, s50
    v_lshrrev_b32 v238, v248, s12
    v_bfi_b32 v1, s69, v238, v0
    buffer_store_dword v1, v236, s[24:27], s11 offen sc1
L_role:
    s_cmp_lg_u32 s3, 1
    s_cbranch_scc1 L_fin
L_role1:
    s_cmp_ge_u32 s68, 28
    s_cbranch_scc1 L_fin
    s_mov_b32 s14, 200000
L_z0:
    buffer_load_dwordx4 v[48:51], v231, s[24:27], 0 offen sc1
    buffer_load_dwordx4 v[52:55], v231, s[24:27], s44 offen sc1
    s_sub_u32 s14, s14, 1
    s_waitcnt vmcnt(0)
    s_cbranch_scc1 L_z1
    v_xor_b32_sdwa v48, v48, s15 dst_sel:DWORD dst_unused:UNUSED_PAD src0_sel:DWORD src1_sel:BYTE_0
    v_xor_b32_sdwa v49, v49, s15 dst_sel:DWORD dst_unused:UNUSED_PAD src0_sel:DWORD src1_sel:BYTE_1
    v_xor_b32_sdwa v50, v50, s15 dst_sel:DWORD dst_unused:UNUSED_PAD src0_sel:DWORD src1_sel:BYTE_2
    v_xor_b32_sdwa v51, v51, s15 dst_sel:DWORD dst_unused:UNUSED_PAD src0_sel:DWORD src1_sel:BYTE_3
    v_xor_b32_sdwa v52, v52, s15 dst_sel:DWORD dst_unused:UNUSED_PAD src0_sel:DWORD src1_sel:BYTE_0
    v_xor_b32_sdwa v53, v53, s15 dst_sel:DWORD dst_unused:UNUSED_PAD src0_sel:DWORD src1_sel:BYTE_1
    v_xor_b32_sdwa v54, v54, s15 dst_sel:DWORD dst_unused:UNUSED_PAD src0_sel:DWORD src1_sel:BYTE_2
    v_xor_b32_sdwa v55, v55, s15 dst_sel:DWORD dst_unused:UNUSED_PAD src0_sel:DWORD src1_sel:BYTE_3
    v_or3_b32 v56, v48, v49, v50
    v_or3_b32 v56, v56, v51, v52
    v_or3_b32 v56, v56, v53, v54
    v_or_b32 v56, v56, v55
    v_cmp_ne_u32_sdwa vcc, v56, 0 src0_sel:BYTE_0 src1_sel:DWORD
    s_and_b64 exec, vcc, vcc
    s_cbranch_scc1 L_z0
L_z1:
    s_mov_b64 exec, -1
    v_add_f32 v48, v48, v52
    v_add_f32 v50, v50, v54
    v_add_f32 v49, v49, v53
    v_add_f32 v51, v51, v55
    v_permlane32_swap_b32 v48, v50
    s_nop 0
    v_permlane32_swap_b32 v49, v51
    v_add_f32 v48, v48, v50
    v_add_f32 v49, v49, v51
    s_nop 1
    v_permlane16_swap_b32 v48, v49
    s_nop 0
    v_add_f32 v48, v48, v49
    s_nop 1
    v_add_f32_dpp v48, v48, v48 row_ror:4 row_mask:0xf bank_mask:0xf
    s_nop 1
    v_add_f32_dpp v48, v48, v48 row_ror:8 row_mask:0xf bank_mask:0xf
    v_cvt_pk_bf16_f32 v48, v48, v48
    s_mov_b32 exec_lo, 0x000f000f
    s_mov_b32 exec_hi, 0x000f000f
    buffer_store_short v48, v232, s[36:39], 0 offen
    s_cmp_lg_u32 s2, 0
    s_cbranch_scc1 L_fin
    s_mov_b64 exec, 1
    buffer_store_dword v251, off, s[24:27], 0 sc1
L_fin:
L_end:
    s_endpgm
L_mlB:
    s_lshr_b32 s12, s49, 24
    s_add_u32 s11, s13, s50
    v_xor_b32 v247, s12, v247
    buffer_store_dwordx4 v[244:247], v242, s[24:27], s11 offen sc1
    s_branch L_mlR
L_gr15:
    s_mov_b32 exec_hi, 0
    buffer_store_dword v191, v188, s[24:27], s61 offen offset:0 sc1
    s_mov_b64 exec, -1
    s_branch L_gs15
L_gr16:
    s_mov_b32 exec_hi, 0
    buffer_store_dword v191, v188, s[24:27], s61 offen offset:0 sc1
    s_mov_b64 exec, -1
    s_branch L_gs16
L_gr17:
    s_mov_b32 exec_hi, 0
    buffer_store_dword v191, v188, s[24:27], s61 offen offset:0 sc1
    s_mov_b64 exec, -1
    s_branch L_gs17
L_gr18:
    s_mov_b32 exec_hi, 0
    buffer_store_dword v191, v188, s[24:27], s61 offen offset:0 sc1
    s_mov_b64 exec, -1
    s_branch L_gs18
L_gr19:
    s_mov_b32 exec_hi, 0
    buffer_store_dword v191, v188, s[24:27], s61 offen offset:0 sc1
    s_mov_b64 exec, -1
    s_branch L_gs19
L_gr20:
    s_mov_b32 exec_hi, 0
    buffer_store_dword v191, v188, s[24:27], s61 offen offset:0 sc1
    s_mov_b64 exec, -1
    s_branch L_gs20
L_gr21:
    s_mov_b32 exec_hi, 0
    buffer_store_dword v191, v188, s[24:27], s61 offen offset:0 sc1
    s_mov_b64 exec, -1
    s_branch L_gs21
L_gr22:
    s_mov_b32 exec_hi, 0
    buffer_store_dword v191, v188, s[24:27], s61 offen offset:0 sc1
    s_mov_b64 exec, -1
    s_branch L_gs22
L_gq19:
    buffer_load_dword v189, v190, s[24:27], s61 offen offset:0 sc1
    s_branch L_gt19
L_gq24:
    s_waitcnt vmcnt(5)
    v_cmp_eq_u32 s[46:47], v189, v191
    s_lshr_b32 s11, s6, 1
    s_lshl_b64 exec, 1, s11
    s_bcnt1_i32_b64 s11, s[46:47]
    v_xor_b32 v189, s11, v251
    buffer_store_dword v189, v188, s[24:27], s72 offen offset:0
    s_mov_b64 exec, -1
    s_branch L_gt24
L_slow:
    s_waitcnt lgkmcnt(0)
    s_barrier
    s_mov_b32 s50, 2097152
    s_mov_b32 s51, s49
    s_cmp_ge_u32 s3, 4
    s_cbranch_scc1 L_slow1
    s_lshr_b32 s12, s49, 24
    s_add_u32 s11, s100, 2097152
    v_xor_b32 v211, s12, v211
    s_mov_b32 exec_lo, 0x00ff00ff
    s_mov_b32 exec_hi, 0x00ff00ff
    buffer_store_dwordx4 v[208:211], v228, s[24:27], s11 offen sc1
    s_mov_b64 exec, -1
L_slow1:
    s_mov_b32 s55, s40
    s_mov_b32 s14, 200000
    buffer_load_dwordx4 v[244:247], v242, s[24:27], s55 offen sc1 nt
    s_waitcnt vmcnt(0)
    s_branch L_qa
    .fill (10240 + 256 - (. - standalone__sliding_block_cached__decode_kernel)) / 4, 4, 0xbf810000
.section .rodata,"a"
.p2align 6
.amdhsa_kernel standalone__sliding_block_cached__decode_kernel
  .amdhsa_next_free_vgpr 256
  .amdhsa_next_free_sgpr 102
  .amdhsa_accum_offset 256
  .amdhsa_group_segment_fixed_size 0
  .amdhsa_kernarg_size 64
  .amdhsa_user_sgpr_count 2
  .amdhsa_user_sgpr_kernarg_segment_ptr 1
  .amdhsa_system_sgpr_workgroup_id_x 1
.end_amdhsa_kernel
```
